```python
import torch

def _softmax(x, axis=-1):
    return torch.softmax(x, dim=axis)

def _gelu(x):
    return torch.nn.functional.gelu(x, approximate='tanh')

def _silu(x):
    return torch.nn.functional.silu(x)

def _sigmoid(x):
    return torch.sigmoid(x)

def _layernorm(x, axis=-1, eps=1e-05):
    m = x.mean(dim=axis, keepdim=True)
    v = x.var(dim=axis, keepdim=True, unbiased=False)
    return (x - m) / torch.sqrt(v + eps)

def _scatter_add(tgt, idx, src, axis=0):
    return tgt.clone().index_add_(axis, idx, src)

def _segment_sum(src, seg, n):
    out = torch.zeros((n,) + src.shape[1:], dtype=src.dtype)
    return out.index_add_(0, seg, src)

def _pad(x, pw):
    flat = tuple((v for pair in reversed(pw) for v in pair))
    return torch.nn.functional.pad(x, flat)
kernel_name = 'standalone__window_attn_twins__vision'

def setup_inputs():

    _w = lambda a: (lambda t: t.to(torch.bfloat16) if t.is_floating_point() else t)(torch.as_tensor(a))
    H = W = 224 // 8 * 8
    C = 96
    return {'x': _w((lambda *s: torch.randn(*s, dtype=torch.bfloat16) * 0.8)(1, H, W, C)), 'wq': _w((lambda *s: torch.randn(*s, dtype=torch.bfloat16) * 0.8)(C, C)), 'wkv': _w((lambda *s: torch.randn(*s, dtype=torch.bfloat16) * 0.8)(C, 2 * C)), 'wo': _w((lambda *s: torch.randn(*s, dtype=torch.bfloat16) * 0.05)(C, C))}

def reference(x, wq, wkv, wo):
    B, H, W, C = x.shape
    win = 8
    nh, nw = (H // win, W // win)
    xs = x.reshape(B, nh, win, nw, win, C).mean(axis=(2, 4)).reshape(B, nh * nw, C)
    q = x.reshape(B, H * W, C) @ wq
    kv = xs @ wkv
    k, v = (kv[..., :C].clone(), kv[..., C:].clone())
    scale = C ** (-0.5)
    p = _softmax(torch.einsum('bqc,bkc->bqk', q, k) * scale, axis=-1)
    o = torch.einsum('bqk,bkc->bqc', p, v) @ wo
    return o.reshape(B, H, W, C)
```

```asm
; @launch grid=(256,1,1) block=(768,1,1) lds=163840
.amdgcn_target "amdgcn-amd-amdhsa--gfx950"
.text
.p2align 8
.globl standalone__window_attn_twins__vision_kernel
.type standalone__window_attn_twins__vision_kernel,@function
standalone__window_attn_twins__vision_kernel:
s_cmp_ge_u32 s2, 256
s_cbranch_scc1 L_end
s_load_dwordx8 s[4:11], s[0:1], 0
s_load_dwordx4 s[12:15], s[0:1], 32
s_load_dwordx2 s[16:17], s[0:1], 48
v_lshrrev_b32 v1, 6, v0
v_mul_u32_u24 v140, 683, v0
v_readfirstlane_b32 s44, v1
v_lshrrev_b32 v140, 16, v140
v_mul_u32_u24 v141, 96, v140
v_sub_u32 v141, v0, v141
v_mul_u32_u24 v142, 5462, v0
v_bfe_u32 v142, v142, 18, 2
v_xor_b32 v143, v141, v142
v_mul_u32_u24 v160, 43008, v140
v_lshl_add_u32 v160, v143, 4, v160
v_xor_b32 v144, v0, v142
v_lshlrev_b32 v144, 4, v144
v_mul_u32_u24 v145, 2731, v0
v_lshrrev_b32 v145, 16, v145
v_and_b32 v146, 2, v145
v_lshrrev_b32 v145, 1, v145
v_and_b32 v145, 4, v145
v_or_b32 v145, v145, v146
v_xor_b32 v145, v0, v145
v_lshlrev_b32 v145, 4, v145
v_and_b32 v0, 63, v0
v_lshlrev_b32 v4, 4, v0
s_and_b32 s1, s2, 7
s_lshl_b32 s1, s1, 5
s_lshr_b32 s58, s2, 3
s_or_b32 s1, s1, s58
s_mul_i32 s58, s2, 3
s_mul_i32 s56, s58, 9363
s_lshr_b32 s56, s56, 18
s_mul_i32 s57, s56, 28
s_sub_u32 s57, s58, s57
s_mul_i32 s56, s56, 344064
s_mul_i32 s57, s57, 1536
s_add_u32 s48, s56, s57
s_add_u32 s58, s58, 1
s_mul_i32 s56, s58, 9363
s_lshr_b32 s56, s56, 18
s_mul_i32 s57, s56, 28
s_sub_u32 s57, s58, s57
s_mul_i32 s56, s56, 344064
s_mul_i32 s57, s57, 1536
s_add_u32 s49, s56, s57
s_add_u32 s58, s58, 1
s_mul_i32 s56, s58, 9363
s_lshr_b32 s56, s56, 18
s_mul_i32 s57, s56, 28
s_sub_u32 s57, s58, s57
s_mul_i32 s56, s56, 344064
s_mul_i32 s57, s57, 1536
s_add_u32 s50, s56, s57
s_lshr_b32 s59, s1, 4
s_add_u32 s58, s59, 768
s_mul_i32 s56, s58, 9363
s_lshr_b32 s56, s56, 18
s_mul_i32 s57, s56, 28
s_sub_u32 s57, s58, s57
s_mul_i32 s56, s56, 344064
s_mul_i32 s57, s57, 1536
s_add_u32 s51, s56, s57
s_lshl_b32 s62, s44, 10
s_waitcnt lgkmcnt(0)
s_mov_b32 s20, s4
s_and_b32 s21, s5, 0xffff
s_mov_b32 s22, 9633792
s_mov_b32 s23, 0x20000
s_mov_b32 s28, s8
s_and_b32 s29, s9, 0xffff
s_mov_b32 s30, 36864
s_mov_b32 s31, 0x20000
s_add_u32 s56, s62, 98304
s_mov_b32 s57, s62
s_mov_b32 s66, 0
s_mov_b32 m0, s56
s_add_u32 s56, s56, 12288
buffer_load_dwordx4 v160, s[20:23], s48 offen  lds
s_mov_b32 m0, s57
s_add_u32 s57, s57, 12288
buffer_load_dwordx4 v145, s[28:31], s66 offen lds
s_add_u32 s66, s66, 12288
s_mov_b32 m0, s56
s_add_u32 s56, s56, 12288
buffer_load_dwordx4 v160, s[20:23], s49 offen  lds
s_mov_b32 m0, s57
s_add_u32 s57, s57, 12288
buffer_load_dwordx4 v145, s[28:31], s66 offen lds
s_add_u32 s66, s66, 12288
s_mov_b32 m0, s56
s_add_u32 s56, s56, 12288
buffer_load_dwordx4 v160, s[20:23], s50 offen  lds
s_mov_b32 m0, s57
s_add_u32 s57, s57, 12288
buffer_load_dwordx4 v145, s[28:31], s66 offen lds
s_add_u32 s66, s66, 12288
s_mov_b32 m0, s56
s_add_u32 s56, s56, 12288
buffer_load_dwordx4 v160, s[20:23], s51 offen  lds
s_mov_b32 s24, s6
s_and_b32 s25, s7, 0xffff
s_mov_b32 s26, 18432
s_mov_b32 s27, 0x20000
s_mov_b32 s32, s10
s_and_b32 s33, s11, 0xffff
s_mov_b32 s34, 18432
s_mov_b32 s35, 0x20000
s_mov_b32 s36, s16
s_and_b32 s37, s17, 0xffff
s_mov_b32 s38, 3801088
s_mov_b32 s39, 0x20000
s_mov_b32 s40, s12
s_and_b32 s41, s13, 0xffff
s_mov_b32 s42, 9633792
s_mov_b32 s43, 0x20000
s_barrier
s_add_u32 s56, s62, 36864
s_mov_b32 m0, s56
s_nop 0
buffer_load_dwordx4 v144, s[32:35], 0 offen lds
s_add_u32 s56, s56, 12288
s_mov_b32 m0, s56
s_mov_b32 s57, 12288
buffer_load_dwordx4 v144, s[32:35], s57 offen lds
s_mov_b64 s[66:67], s[4:5]
v_mov_b32 v146, 0
s_cmp_lt_u32 s44, 4
s_cselect_b64 s[66:67], s[16:17], s[66:67]
s_cselect_b32 s56, 475136, 0
s_cselect_b32 s57, 0x3fff80, 0
s_cmp_eq_u32 s44, 4
s_cselect_b64 s[66:67], s[12:13], s[66:67]
s_cselect_b32 s56, s48, s56
s_cselect_b32 s57, s50, s57
s_cselect_b32 s68, s51, s56
v_writelane_b32 v146, s56, 0
v_writelane_b32 v146, s57, 1
v_writelane_b32 v146, s68, 2
s_mov_b64 exec, 7
global_load_dword v147, v146, s[66:67] sc1
s_mov_b64 exec, -1
v_mul_u32_u24 v161, 12800, v140
v_lshrrev_b32 v146, 3, v141
v_lshl_add_u32 v161, v146, 10, v161
v_bfe_u32 v146, v141, 2, 1
v_lshl_add_u32 v161, v146, 9, v161
v_and_b32 v146, 3, v141
v_lshl_add_u32 v161, v146, 4, v161
s_and_b32 s45, s44, 1
s_lshr_b32 s63, s44, 1
s_add_u32 s46, s63, 4
s_cmp_ge_u32 s46, 6
s_cselect_b32 s56, 6, 0
s_sub_u32 s46, s46, s56
s_and_b32 s58, s1, 7
s_cmp_ge_u32 s44, 6
s_cselect_b32 s64, 1, 0
s_mul_i32 s65, s64, 6
s_sub_u32 s65, s44, s65
v_and_b32 v116, 15, v0
v_lshrrev_b32 v117, 4, v0
v_and_b32 v118, 3, v0
v_lshrrev_b32 v119, 2, v116
v_lshl_add_u32 v119, v117, 3, v119
v_and_b32 v120, 1, v118
v_lshlrev_b32 v120, 3, v120
v_lshrrev_b32 v137, 1, v118
s_lshl_b32 s56, s65, 1
v_add_u32 v138, s56, v137
v_lshlrev_b32 v139, 1, v117
v_and_b32 v139, 3, v139
v_xor_b32 v138, v138, v139
v_mul_u32_u24 v121, 192, v119
v_add_u32 v121, v121, v120
v_xor_b32 v139, 1, v138
v_lshl_add_u32 v152, v139, 4, v121
v_lshl_add_u32 v121, v138, 4, v121
v_add_u32 v123, 36864, v121
v_add_u32 v153, 36864, v152
s_mul_i32 s57, s64, 24576
s_add_u32 s57, s57, 98304
v_add_u32 v121, s57, v121
v_add_u32 v152, s57, v152
s_lshl_b32 s57, s44, 1
v_add_u32 v138, s57, v137
v_and_b32 v139, 2, v119
v_xor_b32 v138, v138, v139
v_and_b32 v139, 1, v117
v_lshlrev_b32 v139, 2, v139
v_xor_b32 v138, v138, v139
v_mul_u32_u24 v122, 384, v119
v_add_u32 v122, v122, v120
v_lshl_add_u32 v122, v138, 4, v122
s_lshl_b32 s56, s65, 5
s_mul_i32 s57, s64, 384
s_add_u32 s57, s57, s56
s_add_u32 s57, s57, 61440
v_lshl_add_u32 v124, v117, 3, s57
v_mul_u32_u24 v125, 192, v118
v_lshl_add_u32 v125, v117, 4, v125
v_add_u32 v125, 61440, v125
v_mul_u32_u24 v126, 384, v118
s_mul_i32 s57, s64, 192
s_add_u32 s57, s57, 62464
v_lshl_add_u32 v127, v117, 4, v126
v_add_u32 v127, s57, v127
s_lshl_b32 s57, s44, 5
s_add_u32 s57, s57, 62464
v_lshl_add_u32 v126, v117, 3, v126
v_add_u32 v126, s57, v126
v_and_b32 v128, 31, v0
v_bfe_u32 v129, v0, 2, 2
v_lshrrev_b32 v130, 5, v0
v_xor_b32 v129, v129, v130
v_mul_u32_u24 v128, 192, v128
v_lshl_add_u32 v128, v129, 4, v128
s_bfe_u32 s56, s1, 0x10003
s_add_u32 s56, s56, 6
s_mul_i32 s57, s56, 6144
s_add_u32 s57, s57, 98304
v_add_u32 v163, s57, v128
s_mul_i32 s57, s46, 6144
s_add_u32 s57, s57, 98304
v_add_u32 v128, s57, v128
v_xor_b32 v129, 32, v128
s_cmp_eq_u32 s58, 7
s_cselect_b32 s56, 0xa5, 37
s_lshr_b32 s3, s56, s44
s_and_b32 s3, s3, 1
s_cmp_eq_u32 s64, 1
s_cselect_b64 s[66:67], -1, 0
v_cndmask_b32 v130, v116, v117, s[66:67]
s_mul_i32 s56, s2, 3
v_add_u32 v131, s56, v130
s_add_u32 s57, s59, 768
v_mov_b32 v132, s57
v_cmp_eq_u32 vcc, 3, v130
s_nop 1
v_cndmask_b32 v131, v131, v132, vcc
v_lshrrev_b32 v132, 5, v131
v_mul_u32_u24 v132, 12288, v132
s_cmp_eq_u32 s64, 1
s_cbranch_scc1 L_vaddr
v_and_b32 v133, 31, v131
v_lshl_add_u32 v132, v133, 4, v132
v_lshrrev_b32 v133, 1, v117
v_lshl_add_u32 v132, v133, 9, v132
v_and_b32 v133, 1, v117
v_lshl_add_u32 v132, v133, 3, v132
v_add_u32 v132, s62, v132
v_mul_u32_u24 v134, 192, v116
v_lshl_add_u32 v134, v117, 4, v134
s_mul_i32 s66, s44, 3072
buffer_load_dwordx4 v[88:91], v134, s[24:27], s66 offen offset:0
buffer_load_dwordx4 v[92:95], v134, s[24:27], s66 offen offset:64
buffer_load_dwordx4 v[96:99], v134, s[24:27], s66 offen offset:128
s_mov_b32 s68, 0x00070007
s_and_b32 s56, s1, 15
s_cmp_eq_u32 s56, 0
s_cselect_b32 s68, 0x000f000f, s68
s_mov_b32 s69, s68
s_branch L_addr_done
L_vaddr:
v_bfe_u32 v133, v131, 4, 1
v_mul_u32_u24 v133, 3072, v133
v_add_u32 v132, v132, v133
v_bfe_u32 v133, v131, 2, 1
v_lshl_add_u32 v132, v133, 9, v132
v_bfe_u32 v133, v131, 3, 1
v_lshl_add_u32 v132, v133, 3, v132
v_and_b32 v133, 3, v131
v_lshl_add_u32 v132, v133, 1, v132
v_lshl_add_u32 v132, v116, 4, v132
s_lshr_b32 s56, s65, 1
s_lshl_b32 s56, s56, 10
s_and_b32 s57, s65, 1
s_lshl_b32 s57, s57, 8
s_add_u32 s56, s56, s57
s_add_u32 s56, s56, 6144
v_add_u32 v132, s56, v132
v_mov_b32 v134, 0
s_mov_b32 s68, -1
s_mov_b32 s69, 0xffff
s_and_b32 s56, s1, 15
s_cmp_eq_u32 s56, 0
s_cselect_b32 s69, -1, s69
L_addr_done:
v_mov_b32 v48, 0x3c803c80
v_mov_b32 v49, 0x3c803c80
v_mov_b32 v50, 0x3c803c80
v_mov_b32 v51, 0x3c803c80
v_mov_b32 v135, 0
v_lshrrev_b32 v136, 2, v4
v_add_u32 v136, 159744, v136
s_cmp_lg_u32 s44, 0
s_cbranch_scc1 L_nz
ds_write_b32 v136, v135
v_mov_b32 v135, 0xff800000
ds_write_b32 v136, v135 offset:1280
L_nz:
s_cmp_eq_u32 s64, 0
s_cbranch_scc1 L_b1k
s_waitcnt vmcnt(3)
L_b1k:
s_waitcnt vmcnt(6) lgkmcnt(0)
s_barrier
ds_read_b64_tr_b16 v[32:33], v121 offset:0
ds_read_b64_tr_b16 v[34:35], v152 offset:768
ds_read_b64_tr_b16 v[36:37], v121 offset:6144
ds_read_b64_tr_b16 v[38:39], v152 offset:6912
ds_read_b64_tr_b16 v[40:41], v121 offset:12288
ds_read_b64_tr_b16 v[42:43], v152 offset:13056
ds_read_b64_tr_b16 v[44:45], v121 offset:18432
ds_read_b64_tr_b16 v[46:47], v152 offset:19200
s_waitcnt lgkmcnt(6)
v_mfma_f32_16x16x32_bf16 v[52:55], v[32:35], v[48:51], 0
s_waitcnt lgkmcnt(2)
v_mfma_f32_16x16x32_bf16 v[56:59], v[40:43], v[48:51], 0
v_mfma_f32_16x16x32_bf16 v[52:55], v[36:39], v[48:51], v[52:55]
s_waitcnt lgkmcnt(0)
v_mfma_f32_16x16x32_bf16 v[56:59], v[44:47], v[48:51], v[56:59]
s_mov_b32 s56, 0x00010001
s_mov_b32 s57, 0x00010001
s_nop 5
v_cvt_pk_bf16_f32 v52, v52, v53
v_cvt_pk_bf16_f32 v53, v54, v55
v_cvt_pk_bf16_f32 v56, v56, v57
v_cvt_pk_bf16_f32 v57, v58, v59
s_mov_b64 exec, s[56:57]
ds_write_b64 v124, v[52:53]
ds_write_b64 v124, v[56:57] offset:192
s_mov_b64 exec, -1
ds_read_b64_tr_b16 v[60:61], v122 offset:0
ds_read_b64_tr_b16 v[62:63], v122 offset:1536
ds_read_b64_tr_b16 v[64:65], v122 offset:12288
ds_read_b64_tr_b16 v[66:67], v122 offset:13824
ds_read_b64_tr_b16 v[68:69], v122 offset:24576
ds_read_b64_tr_b16 v[70:71], v122 offset:26112
s_cmp_eq_u32 s64, 0
s_cbranch_scc1 L_w1
s_waitcnt vmcnt(0)
L_w1:
s_waitcnt vmcnt(3) lgkmcnt(6)
s_barrier
ds_read_b128 v[72:75], v125 offset:0
ds_read_b128 v[76:79], v125 offset:64
ds_read_b128 v[80:83], v125 offset:128
s_waitcnt lgkmcnt(2)
v_mfma_f32_16x16x32_bf16 v[84:87], v[60:63], v[72:75], 0
s_waitcnt lgkmcnt(1)
v_mfma_f32_16x16x32_bf16 v[84:87], v[64:67], v[76:79], v[84:87]
s_waitcnt lgkmcnt(0)
v_mfma_f32_16x16x32_bf16 v[84:87], v[68:71], v[80:83], v[84:87]
s_mov_b32 s56, 0x000f000f
s_mov_b32 s57, 0x000f000f
s_nop 5
v_cvt_pk_bf16_f32 v84, v84, v85
v_cvt_pk_bf16_f32 v85, v86, v87
s_mov_b64 exec, s[56:57]
ds_write_b64 v126, v[84:85]
s_mov_b64 exec, -1
s_cmp_eq_u32 s64, 0
s_cbranch_scc1 L_nowo
ds_read_b64_tr_b16 v[88:89], v123 offset:0
ds_read_b64_tr_b16 v[90:91], v153 offset:768
ds_read_b64_tr_b16 v[92:93], v123 offset:6144
ds_read_b64_tr_b16 v[94:95], v153 offset:6912
ds_read_b64_tr_b16 v[96:97], v123 offset:12288
ds_read_b64_tr_b16 v[98:99], v153 offset:13056
s_waitcnt lgkmcnt(6)
s_branch L_wo2
L_nowo:
s_waitcnt lgkmcnt(0)
L_wo2:
s_barrier
ds_read_b128 v[100:103], v127 offset:0
ds_read_b128 v[104:107], v127 offset:64
ds_read_b128 v[108:111], v127 offset:128
s_cmp_eq_u32 s64, 1
s_cbranch_scc1 L_bv
s_waitcnt vmcnt(0)
s_waitcnt lgkmcnt(2)
v_mfma_f32_16x16x32_bf16 v[112:115], v[88:91], v[100:103], 0
s_waitcnt lgkmcnt(1)
v_mfma_f32_16x16x32_bf16 v[112:115], v[92:95], v[104:107], v[112:115]
s_waitcnt lgkmcnt(0)
v_mfma_f32_16x16x32_bf16 v[112:115], v[96:99], v[108:111], v[112:115]
s_mov_b32 s56, 0x3e16c740
s_nop 6
v_mul_f32 v112, s56, v112
v_mul_f32 v113, s56, v113
v_mul_f32 v114, s56, v114
v_mul_f32 v115, s56, v115
v_cvt_pk_bf16_f32 v112, v112, v113
v_cvt_pk_bf16_f32 v113, v114, v115
s_mov_b64 exec, s[68:69]
buffer_store_dwordx2 v[112:113], v132, s[36:39], 0 offen sc1
s_branch L_pub
L_bv:
s_waitcnt lgkmcnt(2)
v_mfma_f32_16x16x32_bf16 v[112:115], v[100:103], v[88:91], 0
s_waitcnt lgkmcnt(1)
v_mfma_f32_16x16x32_bf16 v[112:115], v[104:107], v[92:95], v[112:115]
s_waitcnt lgkmcnt(0)
v_mfma_f32_16x16x32_bf16 v[112:115], v[108:111], v[96:99], v[112:115]
v_cmp_eq_u32 vcc, 1, v117
v_cmp_eq_u32 s[56:57], 2, v117
v_cmp_eq_u32 s[66:67], 3, v117
s_nop 4
v_cndmask_b32 v112, v112, v113, vcc
v_cndmask_b32 v112, v112, v114, s[56:57]
v_cndmask_b32 v112, v112, v115, s[66:67]
v_cvt_pk_bf16_f32 v112, v112, v112
s_mov_b64 exec, s[68:69]
buffer_store_short v112, v132, s[36:39], 0 offen sc1
L_pub:
s_mov_b64 exec, -1
ds_read_b128 v[8:11], v128 offset:0
ds_read_b128 v[12:15], v129 offset:0
ds_read_b128 v[16:19], v128 offset:64
ds_read_b128 v[20:23], v129 offset:64
ds_read_b128 v[24:27], v128 offset:128
ds_read_b128 v[28:31], v129 offset:128
v_mov_b32 v32, 0
v_mov_b32 v33, 0
v_mov_b32 v34, 0
v_mov_b32 v35, 0
v_mov_b32 v36, 0
v_mov_b32 v37, 0
v_mov_b32 v38, 0
v_mov_b32 v39, 0
v_mov_b32 v40, 0
v_mov_b32 v41, 0
v_mov_b32 v42, 0
v_mov_b32 v43, 0
v_mov_b32 v44, 0
v_mov_b32 v45, 0
v_mov_b32 v46, 0
v_mov_b32 v47, 0
v_mov_b32 v48, 0
v_mov_b32 v49, 0
v_mov_b32 v50, 0
v_mov_b32 v51, 0
v_mov_b32 v52, 0
v_mov_b32 v53, 0
v_mov_b32 v54, 0
v_mov_b32 v55, 0
v_mov_b32 v56, 0
v_mov_b32 v57, 0
v_mov_b32 v58, 0
v_mov_b32 v59, 0
v_mov_b32 v60, 0
v_mov_b32 v61, 0
v_mov_b32 v62, 0
v_mov_b32 v63, 0
v_mov_b32 v64, 0
v_mov_b32 v65, 0
v_mov_b32 v66, 0
v_mov_b32 v67, 0
v_mov_b32 v68, 0
v_mov_b32 v69, 0
v_mov_b32 v70, 0
v_mov_b32 v71, 0
v_mov_b32 v72, 0
v_mov_b32 v73, 0
v_mov_b32 v74, 0
v_mov_b32 v75, 0
v_mov_b32 v76, 0
v_mov_b32 v77, 0
v_mov_b32 v78, 0
v_mov_b32 v79, 0
v_mov_b32 v5, 0
v_mov_b32 v164, 0
v_mov_b32 v165, 0
v_mov_b32 v166, 0
v_mov_b32 v167, 0
s_cmp_eq_u32 s3, 0
s_cbranch_scc1 L_noql
v_xor_b32 v162, 32, v163
ds_read_b128 v[80:83], v163 offset:0
ds_read_b128 v[84:87], v162 offset:0
ds_read_b128 v[88:91], v163 offset:64
ds_read_b128 v[92:95], v162 offset:64
ds_read_b128 v[164:167], v163 offset:128
ds_read_b128 v[156:159], v162 offset:128
L_noql:
s_mul_i32 s56, s45, 12288
v_add_u32 v1, s56, v4
v_mov_b32 v2, v1
v_add_u32 v3, 49152, v1
s_mov_b32 s55, 98304
s_mov_b32 s47, 0
s_lshl_b32 s52, s44, 11
s_add_u32 s54, s52, 147456
s_add_u32 s52, s52, 49152
s_mul_i32 s57, s58, 3
s_add_u32 s53, s57, s64
s_add_u32 s53, s53, 4
s_cmp_ge_u32 s53, 24
s_cselect_b32 s56, 24, 0
s_sub_u32 s53, s53, s56
s_mul_i32 s53, s53, 12288
s_lshl_b32 s56, s65, 11
s_add_u32 s53, s53, s56
s_add_u32 s68, s57, 3
s_cmp_ge_u32 s68, 24
s_cselect_b32 s68, 0, s68
s_mul_i32 s68, s68, 12288
s_add_u32 s68, s68, s62
s_mul_i32 s56, s44, 11
s_lshr_b32 s56, s56, 5
s_mul_i32 s66, s56, 3
s_sub_u32 s66, s44, s66
s_lshl_b32 s69, s66, 11
s_add_u32 s67, s57, s56
s_cmp_eq_u32 s56, 3
s_cselect_b32 s67, 24, s67
s_mul_i32 s67, s67, 12288
s_add_u32 s67, s67, s69
s_mul_i32 s66, s56, 12288
s_cmp_eq_u32 s56, 3
s_cselect_b32 s66, 147456, s66
s_add_u32 s66, s66, s69
s_cmp_eq_u32 s44, 0
s_cselect_b32 s60, 0, 8
s_mov_b32 s61, -270336
v_lshlrev_b32 v162, 5, v0
v_readfirstlane_b32 s18, v147
s_lshl_b32 s56, s2, 5
s_add_u32 s56, s56, 327680
v_lshlrev_b32 v160, 13, v0
v_add_u32 v160, s56, v160
s_mul_i32 s18, s18, 0x9e3779b1
s_add_u32 s18, s18, 0x7f4a7c15
s_mul_i32 s19, s18, 0x85ebca6b
s_xor_b32 s19, s19, 0xc2b2ae35
v_mov_b32 v6, s18
v_mov_b32 v7, s19
s_waitcnt vmcnt(0) lgkmcnt(0)
s_barrier
s_cmp_gt_u32 s44, 3
s_cbranch_scc1 L_polled
s_cmp_lg_u32 s44, 0
s_cbranch_scc1 L_nofl
s_mov_b64 exec, 255
buffer_store_dwordx2 v[6:7], v160, s[36:39], 0 offen sc1
s_mov_b64 exec, -1
L_nofl:
s_lshr_b32 s57, s2, 0
s_and_b32 s57, s57, 7
s_lshl_b32 s57, s57, 13
s_lshl_b32 s56, s44, 11
s_add_u32 s56, s56, 327680
s_add_u32 s56, s56, s57
s_mov_b32 s57, 0
s_sleep 18
s_branch L_poll
L_poll_s:
L_poll:
buffer_load_dwordx2 v[128:129], v162, s[36:39], s56 offen sc1
s_add_u32 s57, s57, 1
s_waitcnt vmcnt(0)
v_xor_b32 v128, s18, v128
v_xor_b32 v129, s19, v129
v_or_b32 v128, v128, v129
v_cmp_ne_u32 vcc, 0, v128
s_cmp_ge_u32 s57, 200000
s_cbranch_scc1 L_polled2
s_cbranch_vccnz L_poll_s
L_polled2:
s_mov_b64 exec, -1
L_polled:
s_barrier
s_mov_b32 m0, s66
s_nop 0
buffer_load_dwordx4 v4, s[36:39], s67 offen sc1 lds
buffer_load_dwordx4 v4, s[36:39], s67 offen offset:1024 sc1 lds
s_add_u32 m0, s66, 6144
s_add_u32 s67, s67, 6144
s_barrier
buffer_load_dwordx4 v4, s[36:39], s67 offen sc1 lds
buffer_load_dwordx4 v4, s[36:39], s67 offen offset:1024 sc1 lds
s_add_u32 m0, s62, 36864
v_add_u32 v160, 147456, v4
buffer_load_dwordx4 v4, s[36:39], s68 offen sc1 lds
s_waitcnt vmcnt(3)
s_barrier
s_lshr_b32 s56, 0xa5a, s44
s_and_b32 s56, s56, 1
s_cbranch_scc0 L_pathN
ds_read_b128 v[128:131], v160 offset:0
ds_read_b128 v[132:135], v160 offset:1024
ds_read_b128 v[136:139], v160 offset:2048
ds_read_b128 v[140:143], v160 offset:3072
ds_read_b128 v[144:147], v160 offset:4096
ds_read_b128 v[148:151], v160 offset:5120
ds_read_b128 v[152:155], v2 offset:0
ds_read_b128 v[156:159], v2 offset:1024
s_waitcnt lgkmcnt(7)
v_mfma_f32_32x32x16_bf16 v[112:127], v[128:131], v[8:11], 0
ds_read_b128 v[128:131], v2 offset:2048
s_waitcnt lgkmcnt(7)
v_mfma_f32_32x32x16_bf16 v[112:127], v[132:135], v[12:15], v[112:127]
ds_read_b128 v[132:135], v2 offset:3072
s_waitcnt lgkmcnt(7)
v_mfma_f32_32x32x16_bf16 v[112:127], v[136:139], v[16:19], v[112:127]
ds_read_b128 v[136:139], v2 offset:4096
s_waitcnt lgkmcnt(7)
v_mfma_f32_32x32x16_bf16 v[112:127], v[140:143], v[20:23], v[112:127]
ds_read_b128 v[140:143], v2 offset:5120
s_waitcnt lgkmcnt(7)
v_mfma_f32_32x32x16_bf16 v[112:127], v[144:147], v[24:27], v[112:127]
s_waitcnt lgkmcnt(6)
v_mfma_f32_32x32x16_bf16 v[112:127], v[148:151], v[28:31], v[112:127]
s_barrier
s_mov_b32 m0, s52
s_nop 0
buffer_load_dwordx4 v4, s[36:39], s53 offen sc1 lds
s_mov_b32 m0, s52
s_add_u32 s52, s52, 24576
buffer_load_dwordx4 v4, s[36:39], s53 offen offset:1024 sc1 lds
s_add_u32 s53, s53, 24576
s_cmp_ge_u32 s52, s54
s_cselect_b32 s56, 147456, 0
s_sub_u32 s52, s52, s56
s_cmp_ge_u32 s53, 294912
s_cselect_b32 s56, 294912, 0
s_sub_u32 s53, s53, s56
v_max3_f32 v6, v112, v113, v114
v_max3_f32 v6, v6, v115, v116
v_max3_f32 v6, v6, v117, v118
v_max_f32 v6, v6, v119
v_mov_b32 v7, v6
s_nop 1
v_permlane32_swap_b32 v6, v7
s_nop 1
v_max_f32 v6, v6, v7
v_sub_f32 v80, 0, v6
v_sub_f32 v81, 0, v6
v_sub_f32 v82, 0, v6
v_sub_f32 v83, 0, v6
v_sub_f32 v84, 0, v6
v_sub_f32 v85, 0, v6
v_sub_f32 v86, 0, v6
v_sub_f32 v87, 0, v6
v_sub_f32 v88, 0, v6
v_sub_f32 v89, 0, v6
v_sub_f32 v90, 0, v6
v_sub_f32 v91, 0, v6
v_sub_f32 v92, 0, v6
v_sub_f32 v93, 0, v6
v_sub_f32 v94, 0, v6
v_sub_f32 v95, 0, v6
v_sub_f32 v120, v112, v6
v_sub_f32 v121, v113, v6
v_sub_f32 v122, v114, v6
v_sub_f32 v123, v115, v6
v_sub_f32 v124, v116, v6
v_sub_f32 v125, v117, v6
v_sub_f32 v126, v118, v6
v_sub_f32 v127, v119, v6
s_waitcnt lgkmcnt(0)
v_mfma_f32_32x32x16_bf16 v[96:111], v[152:155], v[8:11], v[80:95]
v_exp_f32 v120, v120
v_exp_f32 v121, v121
v_add_f32 v5, v5, v120
v_exp_f32 v122, v122
v_mfma_f32_32x32x16_bf16 v[96:111], v[156:159], v[12:15], v[96:111]
v_add_f32 v5, v5, v121
v_cvt_pk_bf16_f32 v164, v120, v121
v_exp_f32 v123, v123
v_add_f32 v5, v5, v122
v_mfma_f32_32x32x16_bf16 v[96:111], v[128:131], v[16:19], v[96:111]
v_exp_f32 v124, v124
v_add_f32 v5, v5, v123
v_cvt_pk_bf16_f32 v165, v122, v123
v_exp_f32 v125, v125
v_mfma_f32_32x32x16_bf16 v[96:111], v[132:135], v[20:23], v[96:111]
v_add_f32 v5, v5, v124
v_exp_f32 v126, v126
v_add_f32 v5, v5, v125
v_cvt_pk_bf16_f32 v166, v124, v125
v_mfma_f32_32x32x16_bf16 v[96:111], v[136:139], v[24:27], v[96:111]
v_exp_f32 v127, v127
v_add_f32 v5, v5, v126
v_cvt_pk_bf16_f32 v167, v126, v127
v_add_f32 v5, v5, v127
v_mfma_f32_32x32x16_bf16 v[96:111], v[140:143], v[28:31], v[96:111]
s_mov_b32 m0, s52
s_nop 0
buffer_load_dwordx4 v4, s[36:39], s53 offen sc1 lds
s_mov_b32 m0, s52
s_add_u32 s52, s52, 24576
buffer_load_dwordx4 v4, s[36:39], s53 offen offset:1024 sc1 lds
s_add_u32 s53, s53, 24576
s_cmp_ge_u32 s52, s54
s_cselect_b32 s56, 147456, 0
s_sub_u32 s52, s52, s56
s_cmp_ge_u32 s53, 294912
s_cselect_b32 s56, 294912, 0
s_sub_u32 s53, s53, s56
s_cmp_gt_u32 s63, 2
s_cbranch_scc1 L_pre
s_lshl_b32 s56, s63, 10
v_add_u32 v162, s56, v4
v_add_u32 v163, 122880, v4
s_mul_i32 s57, s1, 12800
s_add_u32 s57, s57, 524288
s_lshl_b32 s56, s63, 12
s_add_u32 s56, s56, s57
s_add_u32 s57, s57, 12288
s_waitcnt vmcnt(2)
s_barrier
ds_read_b128 v[128:131], v162 offset:6144
ds_read_b128 v[132:135], v163 offset:0
ds_read_b128 v[136:139], v162 offset:9216
ds_read_b128 v[140:143], v163 offset:1024
ds_read_b128 v[144:147], v162 offset:18432
ds_read_b128 v[148:151], v163 offset:2048
ds_read_b128 v[152:155], v162 offset:21504
ds_read_b128 v[156:159], v163 offset:3072
s_waitcnt lgkmcnt(6)
v_mfma_f32_32x32x16_bf16 v[112:127], v[128:131], v[132:135], 0
ds_read_b128 v[128:131], v162 offset:30720
ds_read_b128 v[132:135], v163 offset:4096
s_waitcnt lgkmcnt(6)
v_mfma_f32_32x32x16_bf16 v[112:127], v[136:139], v[140:143], v[112:127]
ds_read_b128 v[136:139], v162 offset:33792
ds_read_b128 v[140:143], v163 offset:5120
s_waitcnt lgkmcnt(6)
v_mfma_f32_32x32x16_bf16 v[112:127], v[144:147], v[148:151], v[112:127]
s_waitcnt lgkmcnt(4)
v_mfma_f32_32x32x16_bf16 v[112:127], v[152:155], v[156:159], v[112:127]
s_waitcnt lgkmcnt(2)
v_mfma_f32_32x32x16_bf16 v[112:127], v[128:131], v[132:135], v[112:127]
s_waitcnt lgkmcnt(0)
v_mfma_f32_32x32x16_bf16 v[112:127], v[136:139], v[140:143], v[112:127]
s_cmp_lg_u32 s58, 7
s_cbranch_scc1 L_b7
v_add_u32 v7, 147456, v162
ds_read_b128 v[144:147], v7 offset:6144
ds_read_b128 v[148:151], v163 offset:6144
s_waitcnt lgkmcnt(0)
v_mfma_f32_32x32x16_bf16 v[112:127], v[144:147], v[148:151], v[112:127]
L_b7:
v_and_b32 v162, 31, v0
v_lshlrev_b32 v162, 2, v162
v_add_u32 v162, 160256, v162
ds_read_b32 v128, v162 offset:0
ds_read_b32 v129, v162 offset:256
ds_read_b32 v130, v162 offset:512
ds_read_b32 v131, v162 offset:768
ds_read_b32 v132, v162 offset:1024
ds_read_b32 v133, v162 offset:1280
ds_read_b32 v134, v162 offset:1536
ds_read_b32 v135, v162 offset:1792
v_lshrrev_b32 v163, 1, v4
s_waitcnt lgkmcnt(0)
v_max3_f32 v136, v128, v129, v130
v_max_f32 v136, v136, v131
v_add_f32 v137, v132, v133
v_add_f32 v137, v137, v134
s_cmp_lg_u32 s58, 7
s_cbranch_scc1 L_b8
v_add_f32 v137, v137, v135
L_b8:
buffer_store_dwordx4 v[112:115], v4, s[36:39], s56 offen offset:0 sc1
buffer_store_dwordx4 v[116:119], v4, s[36:39], s56 offen offset:1024 sc1
buffer_store_dwordx4 v[120:123], v4, s[36:39], s56 offen offset:2048 sc1
buffer_store_dwordx4 v[124:127], v4, s[36:39], s56 offen offset:3072 sc1
s_cmp_lg_u32 s44, 1
s_cbranch_scc1 L_b9
buffer_store_dwordx2 v[136:137], v163, s[36:39], s57 offen sc1
L_b9:
s_mov_b32 s3, 2
s_branch L_pre2
L_pathN:
s_cmp_eq_u32 s3, 0
s_cbranch_scc1 L_noL
s_mul_i32 s56, s63, 12288
s_cmp_eq_u32 s63, 3
s_cselect_b32 s56, 147456, s56
v_add_u32 v162, s56, v4
ds_read_b128 v[128:131], v162 offset:0
ds_read_b128 v[132:135], v162 offset:1024
ds_read_b128 v[136:139], v162 offset:2048
ds_read_b128 v[140:143], v162 offset:3072
ds_read_b128 v[144:147], v162 offset:4096
ds_read_b128 v[148:151], v162 offset:5120
s_waitcnt lgkmcnt(5)
v_mfma_f32_32x32x16_bf16 v[112:127], v[128:131], v[80:83], 0
ds_read_b128 v[128:131], v2 offset:0
s_waitcnt lgkmcnt(5)
v_mfma_f32_32x32x16_bf16 v[112:127], v[132:135], v[84:87], v[112:127]
ds_read_b128 v[132:135], v2 offset:1024
s_waitcnt lgkmcnt(5)
v_mfma_f32_32x32x16_bf16 v[112:127], v[136:139], v[88:91], v[112:127]
ds_read_b128 v[136:139], v2 offset:2048
s_waitcnt lgkmcnt(5)
v_mfma_f32_32x32x16_bf16 v[112:127], v[140:143], v[92:95], v[112:127]
ds_read_b128 v[140:143], v2 offset:3072
s_waitcnt lgkmcnt(5)
v_mfma_f32_32x32x16_bf16 v[112:127], v[144:147], v[164:167], v[112:127]
ds_read_b128 v[144:147], v2 offset:4096
s_waitcnt lgkmcnt(5)
v_mfma_f32_32x32x16_bf16 v[112:127], v[148:151], v[156:159], v[112:127]
ds_read_b128 v[148:151], v2 offset:5120
v_and_b32 v162, 31, v0
v_lshlrev_b32 v162, 2, v162
v_add_u32 v162, 160256, v162
s_lshl_b32 s56, s63, 8
v_add_u32 v163, s56, v162
s_nop 4
s_cmp_lg_u32 s63, 3
s_cbranch_scc1 L_full
v_mov_b32 v120, 0xff800000
v_mov_b32 v121, 0xff800000
v_mov_b32 v122, 0xff800000
v_mov_b32 v123, 0xff800000
v_mov_b32 v124, 0xff800000
v_mov_b32 v125, 0xff800000
v_mov_b32 v126, 0xff800000
v_mov_b32 v127, 0xff800000
L_full:
v_max3_f32 v6, v112, v113, v114
v_max3_f32 v6, v6, v115, v116
v_max3_f32 v6, v6, v117, v118
v_max3_f32 v6, v6, v119, v120
v_max3_f32 v6, v6, v121, v122
v_max3_f32 v6, v6, v123, v124
v_max3_f32 v6, v6, v125, v126
v_max_f32 v6, v6, v127
v_mov_b32 v7, v6
s_nop 1
v_permlane32_swap_b32 v6, v7
s_nop 1
v_max_f32 v6, v6, v7
ds_write_b32 v163, v6
s_waitcnt lgkmcnt(0)
s_barrier
ds_read_b32 v152, v162 offset:0
ds_read_b32 v153, v162 offset:256
ds_read_b32 v154, v162 offset:512
ds_read_b32 v155, v162 offset:768
s_lshl_b32 s56, s63, 11
s_add_u32 s56, s56, 122880
v_add_u32 v162, s56, v4
v_mfma_f32_32x32x16_bf16 v[96:111], v[128:131], v[8:11], 0
s_mov_b32 m0, s52
s_nop 0
buffer_load_dwordx4 v4, s[36:39], s53 offen sc1 lds
s_mov_b32 m0, s52
s_add_u32 s52, s52, 24576
buffer_load_dwordx4 v4, s[36:39], s53 offen offset:1024 sc1 lds
s_add_u32 s53, s53, 24576
s_cmp_ge_u32 s52, s54
s_cselect_b32 s56, 147456, 0
s_sub_u32 s52, s52, s56
s_cmp_ge_u32 s53, 294912
s_cselect_b32 s56, 294912, 0
s_sub_u32 s53, s53, s56
s_waitcnt lgkmcnt(0)
v_max3_f32 v6, v152, v153, v154
v_max_f32 v6, v6, v155
v_sub_f32 v112, v112, v6
v_sub_f32 v113, v113, v6
v_sub_f32 v114, v114, v6
v_sub_f32 v115, v115, v6
v_sub_f32 v116, v116, v6
v_sub_f32 v117, v117, v6
v_mfma_f32_32x32x16_bf16 v[96:111], v[132:135], v[12:15], v[96:111]
v_sub_f32 v118, v118, v6
v_sub_f32 v119, v119, v6
v_exp_f32 v112, v112
v_exp_f32 v113, v113
v_exp_f32 v114, v114
v_add_f32 v5, v5, v112
v_exp_f32 v115, v115
v_add_f32 v5, v5, v113
v_mfma_f32_32x32x16_bf16 v[96:111], v[136:139], v[16:19], v[96:111]
v_exp_f32 v116, v116
v_cvt_pk_bf16_f32 v112, v112, v113
v_exp_f32 v117, v117
v_add_f32 v5, v5, v114
v_exp_f32 v118, v118
v_add_f32 v5, v5, v115
v_exp_f32 v119, v119
v_cvt_pk_bf16_f32 v113, v114, v115
v_mfma_f32_32x32x16_bf16 v[96:111], v[140:143], v[20:23], v[96:111]
v_cvt_pk_bf16_f32 v114, v116, v117
v_cvt_pk_bf16_f32 v115, v118, v119
ds_write_b128 v162, v[112:115]
v_sub_f32 v120, v120, v6
v_sub_f32 v121, v121, v6
v_sub_f32 v122, v122, v6
v_sub_f32 v123, v123, v6
v_sub_f32 v124, v124, v6
v_mfma_f32_32x32x16_bf16 v[96:111], v[144:147], v[24:27], v[96:111]
v_sub_f32 v125, v125, v6
v_sub_f32 v126, v126, v6
v_sub_f32 v127, v127, v6
v_exp_f32 v120, v120
v_exp_f32 v121, v121
v_exp_f32 v122, v122
v_add_f32 v5, v5, v120
v_exp_f32 v123, v123
v_mfma_f32_32x32x16_bf16 v[96:111], v[148:151], v[28:31], v[96:111]
v_add_f32 v5, v5, v121
v_exp_f32 v124, v124
v_cvt_pk_bf16_f32 v120, v120, v121
v_exp_f32 v125, v125
v_add_f32 v5, v5, v122
v_exp_f32 v126, v126
v_add_f32 v5, v5, v123
v_exp_f32 v127, v127
v_cvt_pk_bf16_f32 v121, v122, v123
v_cvt_pk_bf16_f32 v122, v124, v125
v_cvt_pk_bf16_f32 v123, v126, v127
ds_write_b128 v162, v[120:123] offset:1024
v_add_f32 v5, v5, v116
v_add_f32 v5, v5, v117
v_add_f32 v5, v5, v118
v_add_f32 v5, v5, v119
v_add_f32 v5, v5, v124
v_add_f32 v5, v5, v125
v_add_f32 v5, v5, v126
v_add_f32 v5, v5, v127
v_mov_b32 v7, v5
s_nop 1
v_permlane32_swap_b32 v5, v7
s_nop 1
v_add_f32 v7, v5, v7
ds_write_b32 v163, v7 offset:1024
s_waitcnt vmcnt(0) lgkmcnt(0)
s_barrier
s_mov_b32 m0, s52
s_nop 0
buffer_load_dwordx4 v4, s[36:39], s53 offen sc1 lds
s_mov_b32 m0, s52
s_add_u32 s52, s52, 24576
buffer_load_dwordx4 v4, s[36:39], s53 offen offset:1024 sc1 lds
s_add_u32 s53, s53, 24576
s_cmp_ge_u32 s52, s54
s_cselect_b32 s56, 147456, 0
s_sub_u32 s52, s52, s56
s_cmp_ge_u32 s53, 294912
s_cselect_b32 s56, 294912, 0
s_sub_u32 s53, s53, s56
v_max3_f32 v6, v96, v97, v98
v_max3_f32 v6, v6, v99, v100
v_max3_f32 v6, v6, v101, v102
v_max3_f32 v6, v6, v103, v104
v_max3_f32 v6, v6, v105, v106
v_max3_f32 v6, v6, v107, v108
v_max3_f32 v6, v6, v109, v110
v_max_f32 v6, v6, v111
v_mov_b32 v7, v6
s_nop 1
v_permlane32_swap_b32 v6, v7
s_nop 1
v_max_f32 v6, v6, v7
v_sub_f32 v80, 0, v6
v_sub_f32 v81, 0, v6
v_sub_f32 v82, 0, v6
v_sub_f32 v83, 0, v6
v_sub_f32 v84, 0, v6
v_sub_f32 v85, 0, v6
v_sub_f32 v86, 0, v6
v_sub_f32 v87, 0, v6
v_sub_f32 v88, 0, v6
v_sub_f32 v89, 0, v6
v_sub_f32 v90, 0, v6
v_sub_f32 v91, 0, v6
v_sub_f32 v92, 0, v6
v_sub_f32 v93, 0, v6
v_sub_f32 v94, 0, v6
v_sub_f32 v95, 0, v6
v_sub_f32 v96, v96, v6
v_sub_f32 v97, v97, v6
v_sub_f32 v98, v98, v6
v_sub_f32 v99, v99, v6
v_sub_f32 v100, v100, v6
v_sub_f32 v101, v101, v6
v_sub_f32 v102, v102, v6
v_sub_f32 v103, v103, v6
v_sub_f32 v104, v104, v6
v_sub_f32 v105, v105, v6
v_sub_f32 v106, v106, v6
v_sub_f32 v107, v107, v6
v_sub_f32 v108, v108, v6
v_sub_f32 v109, v109, v6
v_sub_f32 v110, v110, v6
v_sub_f32 v111, v111, v6
v_mov_b32 v5, 0
v_mov_b32 v164, 0
v_mov_b32 v165, 0
v_mov_b32 v166, 0
v_mov_b32 v167, 0
s_branch L_pre2
L_noL:
ds_read_b128 v[128:131], v2 offset:0
ds_read_b128 v[132:135], v2 offset:1024
ds_read_b128 v[136:139], v2 offset:2048
ds_read_b128 v[140:143], v2 offset:3072
ds_read_b128 v[144:147], v2 offset:4096
ds_read_b128 v[148:151], v2 offset:5120
s_waitcnt lgkmcnt(5)
v_mfma_f32_32x32x16_bf16 v[96:111], v[128:131], v[8:11], 0
s_waitcnt lgkmcnt(4)
v_mfma_f32_32x32x16_bf16 v[96:111], v[132:135], v[12:15], v[96:111]
s_waitcnt lgkmcnt(3)
v_mfma_f32_32x32x16_bf16 v[96:111], v[136:139], v[16:19], v[96:111]
s_waitcnt lgkmcnt(2)
v_mfma_f32_32x32x16_bf16 v[96:111], v[140:143], v[20:23], v[96:111]
s_waitcnt lgkmcnt(1)
v_mfma_f32_32x32x16_bf16 v[96:111], v[144:147], v[24:27], v[96:111]
s_waitcnt lgkmcnt(0)
v_mfma_f32_32x32x16_bf16 v[96:111], v[148:151], v[28:31], v[96:111]
s_barrier
s_mov_b32 m0, s52
s_nop 0
buffer_load_dwordx4 v4, s[36:39], s53 offen sc1 lds
s_mov_b32 m0, s52
s_add_u32 s52, s52, 24576
buffer_load_dwordx4 v4, s[36:39], s53 offen offset:1024 sc1 lds
s_add_u32 s53, s53, 24576
s_cmp_ge_u32 s52, s54
s_cselect_b32 s56, 147456, 0
s_sub_u32 s52, s52, s56
s_cmp_ge_u32 s53, 294912
s_cselect_b32 s56, 294912, 0
s_sub_u32 s53, s53, s56
v_max3_f32 v6, v96, v97, v98
v_max3_f32 v6, v6, v99, v100
v_max3_f32 v6, v6, v101, v102
v_max3_f32 v6, v6, v103, v104
v_max3_f32 v6, v6, v105, v106
v_max3_f32 v6, v6, v107, v108
v_max3_f32 v6, v6, v109, v110
v_max_f32 v6, v6, v111
v_mov_b32 v7, v6
s_nop 1
v_permlane32_swap_b32 v6, v7
s_nop 1
v_max_f32 v6, v6, v7
v_sub_f32 v80, 0, v6
v_sub_f32 v81, 0, v6
v_sub_f32 v82, 0, v6
v_sub_f32 v83, 0, v6
v_sub_f32 v84, 0, v6
v_sub_f32 v85, 0, v6
v_sub_f32 v86, 0, v6
v_sub_f32 v87, 0, v6
v_sub_f32 v88, 0, v6
v_sub_f32 v89, 0, v6
v_sub_f32 v90, 0, v6
v_sub_f32 v91, 0, v6
v_sub_f32 v92, 0, v6
v_sub_f32 v93, 0, v6
v_sub_f32 v94, 0, v6
v_sub_f32 v95, 0, v6
v_sub_f32 v96, v96, v6
v_sub_f32 v97, v97, v6
v_sub_f32 v98, v98, v6
v_sub_f32 v99, v99, v6
v_sub_f32 v100, v100, v6
v_sub_f32 v101, v101, v6
v_sub_f32 v102, v102, v6
v_sub_f32 v103, v103, v6
v_sub_f32 v104, v104, v6
v_sub_f32 v105, v105, v6
v_sub_f32 v106, v106, v6
v_sub_f32 v107, v107, v6
v_sub_f32 v108, v108, v6
v_sub_f32 v109, v109, v6
v_sub_f32 v110, v110, v6
v_sub_f32 v111, v111, v6
s_mov_b32 m0, s52
s_nop 0
buffer_load_dwordx4 v4, s[36:39], s53 offen sc1 lds
s_mov_b32 m0, s52
s_add_u32 s52, s52, 24576
buffer_load_dwordx4 v4, s[36:39], s53 offen offset:1024 sc1 lds
s_add_u32 s53, s53, 24576
s_cmp_ge_u32 s52, s54
s_cselect_b32 s56, 147456, 0
s_sub_u32 s52, s52, s56
s_cmp_ge_u32 s53, 294912
s_cselect_b32 s56, 294912, 0
s_sub_u32 s53, s53, s56
L_pre:
s_waitcnt vmcnt(2)
s_barrier
L_pre2:
ds_read_b128 v[128:131], v2 offset:24576
ds_read_b128 v[132:135], v160 offset:6144
ds_read_b128 v[136:139], v2 offset:25600
ds_read_b128 v[140:143], v160 offset:7168
ds_read_b128 v[144:147], v2 offset:26624
ds_read_b128 v[148:151], v160 offset:8192
ds_read_b128 v[152:155], v2 offset:27648
ds_read_b128 v[156:159], v2 offset:6144
s_nop 3
s_lshl_b32 s54, s44, 11
s_add_u32 s52, s54, 98304
s_branch L_nobar
.p2align 6
L_loop:
s_waitcnt vmcnt(2)
L_entry0:
s_barrier
L_nobar:
s_waitcnt lgkmcnt(6)
v_mfma_f32_32x32x16_bf16 v[112:127], v[128:131], v[8:11], v[80:95]
ds_read_b128 v[128:131], v2 offset:28672
v_exp_f32 v96, v96
v_exp_f32 v97, v97
v_add_f32 v5, v5, v96
s_mov_b32 m0, s52
s_cmp_ge_u32 s53, 270336
buffer_load_dwordx4 v4, s[36:39], s53 offen sc1 lds
s_cselect_b32 s56, s61, 24576
v_mfma_f32_32x32x16_bf16 v[32:47], v[132:135], v[164:167], v[32:47]
ds_read_b128 v[132:135], v2 offset:7168
v_exp_f32 v98, v98
v_add_f32 v5, v5, v97
v_cvt_pk_bf16_f32 v96, v96, v97
s_waitcnt lgkmcnt(6)
v_mfma_f32_32x32x16_bf16 v[112:127], v[136:139], v[12:15], v[112:127]
ds_read_b128 v[136:139], v2 offset:29696
v_exp_f32 v99, v99
v_add_f32 v5, v5, v98
v_exp_f32 v100, v100
v_add_f32 v5, v5, v99
v_mfma_f32_32x32x16_bf16 v[48:63], v[140:143], v[164:167], v[48:63]
ds_read_b128 v[140:143], v2 offset:8192
v_cvt_pk_bf16_f32 v97, v98, v99
v_exp_f32 v101, v101
v_add_f32 v5, v5, v100
s_waitcnt lgkmcnt(6)
v_mfma_f32_32x32x16_bf16 v[112:127], v[144:147], v[16:19], v[112:127]
ds_read_b128 v[144:147], v3 offset:0
v_exp_f32 v102, v102
v_add_f32 v5, v5, v101
v_cvt_pk_bf16_f32 v98, v100, v101
buffer_load_dwordx4 v4, s[36:39], s53 offen offset:1024 sc1 lds
s_add_u32 s53, s53, s56
v_mfma_f32_32x32x16_bf16 v[64:79], v[148:151], v[164:167], v[64:79]
ds_read_b128 v[148:151], v2 offset:9216
v_exp_f32 v103, v103
v_add_f32 v5, v5, v102
v_cvt_pk_bf16_f32 v99, v102, v103
v_add_f32 v5, v5, v103
s_waitcnt lgkmcnt(6)
v_mfma_f32_32x32x16_bf16 v[112:127], v[152:155], v[20:23], v[112:127]
ds_read_b128 v[152:155], v3 offset:1024
v_exp_f32 v104, v104
v_exp_f32 v105, v105
v_add_f32 v5, v5, v104
v_mfma_f32_32x32x16_bf16 v[32:47], v[156:159], v[96:99], v[32:47]
ds_read_b128 v[156:159], v2 offset:10240
v_exp_f32 v106, v106
v_add_f32 v5, v5, v105
v_cvt_pk_bf16_f32 v164, v104, v105
s_waitcnt lgkmcnt(6)
v_mfma_f32_32x32x16_bf16 v[112:127], v[128:131], v[24:27], v[112:127]
ds_read_b128 v[128:131], v3 offset:2048
v_exp_f32 v107, v107
v_add_f32 v5, v5, v106
v_exp_f32 v108, v108
v_add_f32 v5, v5, v107
v_mfma_f32_32x32x16_bf16 v[48:63], v[132:135], v[96:99], v[48:63]
ds_read_b128 v[132:135], v2 offset:11264
v_cvt_pk_bf16_f32 v165, v106, v107
v_exp_f32 v109, v109
v_add_f32 v5, v5, v108
s_waitcnt lgkmcnt(6)
v_mfma_f32_32x32x16_bf16 v[112:127], v[136:139], v[28:31], v[112:127]
ds_read_b128 v[136:139], v3 offset:3072
v_exp_f32 v110, v110
v_add_f32 v5, v5, v109
v_cvt_pk_bf16_f32 v166, v108, v109
v_mfma_f32_32x32x16_bf16 v[64:79], v[140:143], v[96:99], v[64:79]
ds_read_b128 v[140:143], v2 offset:30720
v_exp_f32 v111, v111
v_add_f32 v5, v5, v110
v_cvt_pk_bf16_f32 v167, v110, v111
v_add_f32 v5, v5, v111
s_cmp_eq_u32 s47, 10
s_cbranch_scc1 L_tail
s_waitcnt vmcnt(2)
s_barrier
s_waitcnt lgkmcnt(6)
v_mfma_f32_32x32x16_bf16 v[96:111], v[144:147], v[8:11], v[80:95]
ds_read_b128 v[144:147], v3 offset:4096
v_exp_f32 v112, v112
v_exp_f32 v113, v113
v_add_f32 v5, v5, v112
s_add_u32 m0, s52, 24576
s_cmp_ge_u32 s53, 270336
buffer_load_dwordx4 v4, s[36:39], s53 offen sc1 lds
s_cselect_b32 s56, s61, 24576
v_mfma_f32_32x32x16_bf16 v[32:47], v[148:151], v[164:167], v[32:47]
ds_read_b128 v[148:151], v2 offset:31744
v_exp_f32 v114, v114
v_add_f32 v5, v5, v113
v_cvt_pk_bf16_f32 v112, v112, v113
s_waitcnt lgkmcnt(6)
v_mfma_f32_32x32x16_bf16 v[96:111], v[152:155], v[12:15], v[96:111]
ds_read_b128 v[152:155], v3 offset:5120
v_exp_f32 v115, v115
v_add_f32 v5, v5, v114
v_exp_f32 v116, v116
v_add_f32 v5, v5, v115
v_mfma_f32_32x32x16_bf16 v[48:63], v[156:159], v[164:167], v[48:63]
ds_read_b128 v[156:159], v2 offset:32768
v_cvt_pk_bf16_f32 v113, v114, v115
v_exp_f32 v117, v117
v_add_f32 v5, v5, v116
s_waitcnt lgkmcnt(6)
v_mfma_f32_32x32x16_bf16 v[96:111], v[128:131], v[16:19], v[96:111]
ds_read_b128 v[128:131], v3 offset:24576
v_exp_f32 v118, v118
v_add_f32 v5, v5, v117
v_cvt_pk_bf16_f32 v114, v116, v117
buffer_load_dwordx4 v4, s[36:39], s53 offen offset:1024 sc1 lds
s_add_u32 s53, s53, s56
v_mfma_f32_32x32x16_bf16 v[64:79], v[132:135], v[164:167], v[64:79]
ds_read_b128 v[132:135], v2 offset:33792
v_exp_f32 v119, v119
v_add_f32 v5, v5, v118
v_cvt_pk_bf16_f32 v115, v118, v119
v_add_f32 v5, v5, v119
s_waitcnt lgkmcnt(6)
v_mfma_f32_32x32x16_bf16 v[96:111], v[136:139], v[20:23], v[96:111]
ds_read_b128 v[136:139], v3 offset:25600
v_exp_f32 v120, v120
v_exp_f32 v121, v121
v_add_f32 v5, v5, v120
v_mfma_f32_32x32x16_bf16 v[32:47], v[140:143], v[112:115], v[32:47]
ds_read_b128 v[140:143], v2 offset:34816
v_exp_f32 v122, v122
v_add_f32 v5, v5, v121
v_cvt_pk_bf16_f32 v164, v120, v121
s_waitcnt lgkmcnt(6)
v_mfma_f32_32x32x16_bf16 v[96:111], v[144:147], v[24:27], v[96:111]
ds_read_b128 v[144:147], v3 offset:26624
v_exp_f32 v123, v123
v_add_f32 v5, v5, v122
v_exp_f32 v124, v124
v_add_f32 v5, v5, v123
v_mfma_f32_32x32x16_bf16 v[48:63], v[148:151], v[112:115], v[48:63]
ds_read_b128 v[148:151], v2 offset:35840
v_cvt_pk_bf16_f32 v165, v122, v123
v_exp_f32 v125, v125
v_add_f32 v5, v5, v124
s_waitcnt lgkmcnt(6)
v_mfma_f32_32x32x16_bf16 v[96:111], v[152:155], v[28:31], v[96:111]
ds_read_b128 v[152:155], v3 offset:27648
v_exp_f32 v126, v126
v_add_f32 v5, v5, v125
v_cvt_pk_bf16_f32 v166, v124, v125
v_mfma_f32_32x32x16_bf16 v[64:79], v[156:159], v[112:115], v[64:79]
ds_read_b128 v[156:159], v3 offset:6144
v_exp_f32 v127, v127
v_add_f32 v5, v5, v126
v_cvt_pk_bf16_f32 v167, v126, v127
v_add_f32 v5, v5, v127
v_mov_b32 v2, v3
v_add_u32 v3, s55, v1
s_add_u32 s55, s55, 49152
s_cmp_ge_u32 s55, 147456
s_cselect_b32 s55, 0, s55
s_add_u32 s52, s54, s55
s_add_u32 s47, s47, 2
s_cmp_lt_u32 s47, s60
s_cbranch_scc1 L_loop
s_cmp_eq_u32 s47, 10
s_cbranch_scc1 L_t10
s_cmp_lg_u32 s44, 0
s_cbranch_scc1 L_after
s_cmp_eq_u32 s47, 2
s_cbranch_scc0 Levt5
s_lshl_b32 s56, s1, 5
s_add_u32 s56, s56, 466944
v_mov_b32 v160, s56
v_mov_b32 v162, s18
v_mov_b32 v163, s19
s_mov_b64 exec, 1
buffer_store_dwordx2 v[162:163], v160, s[36:39], 0 offen sc1
s_cmp_lg_u32 s2, 0
s_cbranch_scc1 L_noep
v_mov_b32 v160, 475136
buffer_store_dword v162, v160, s[36:39], 0 offen sc1
L_noep:
s_mov_b64 exec, -1
s_branch L_loop
Levt5:
s_cmp_eq_u32 s47, 8
s_cbranch_scc1 L_after
s_and_b32 s56, s1, 0xf8
s_lshl_b32 s56, s56, 5
s_add_u32 s56, s56, 466944
v_and_b32 v160, 7, v0
v_lshlrev_b32 v160, 5, v160
s_cmp_eq_u32 s47, 4
s_cbranch_scc0 Levt7
buffer_load_dwordx2 v[162:163], v160, s[36:39], s56 offen sc1
s_branch L_loop
Levt7:
s_mov_b32 s57, 0
s_waitcnt vmcnt(4)
Levt7_chk:
v_xor_b32 v162, s18, v162
v_xor_b32 v163, s19, v163
v_or_b32 v162, v162, v163
v_cmp_ne_u32 vcc, 0, v162
s_add_u32 s57, s57, 1
s_cmp_ge_u32 s57, 100000
s_cbranch_scc1 L_loop
s_cbranch_vccz L_loop
buffer_load_dwordx2 v[162:163], v160, s[36:39], s56 offen sc1
s_waitcnt vmcnt(0)
s_branch Levt7_chk
L_after:
s_and_b32 s56, s1, 0xf8
s_mul_i32 s56, s56, 12800
s_add_u32 s56, s56, 524288
s_lshl_b32 s57, s58, 6
s_add_u32 s57, s57, s56
s_add_u32 m0, s62, 147456
v_lshrrev_b32 v160, 3, v0
v_mul_u32_u24 v160, 12800, v160
buffer_load_dwordx4 v161, s[36:39], s57 offen sc1 lds
v_and_b32 v162, 7, v0
v_lshl_add_u32 v160, v162, 2, v160
s_lshl_b32 s57, s58, 5
s_add_u32 s57, s57, s56
s_add_u32 s57, s57, 12288
s_cmp_lg_u32 s44, 0
s_cbranch_scc1 L_nog
s_mov_b32 m0, 160000
s_nop 0
buffer_load_dword v160, s[36:39], s57 offen sc1 lds
L_nog:
s_mov_b32 s53, 0x10000000
s_mov_b32 s61, 0
s_mov_b32 s52, 0x30000
s_branch L_loop
L_t10:
s_mov_b32 s52, 0x30000
s_branch L_loop
L_tail:
ds_read_b128 v[144:147], v2 offset:31744
ds_read_b128 v[152:155], v2 offset:32768
ds_read_b128 v[128:131], v2 offset:33792
ds_read_b128 v[136:139], v2 offset:34816
s_waitcnt lgkmcnt(4)
v_mfma_f32_32x32x16_bf16 v[32:47], v[148:151], v[164:167], v[32:47]
ds_read_b128 v[148:151], v2 offset:35840
v_exp_f32 v112, v112
v_exp_f32 v113, v113
v_add_f32 v5, v5, v112
v_exp_f32 v114, v114
v_add_f32 v5, v5, v113
v_cvt_pk_bf16_f32 v112, v112, v113
v_exp_f32 v115, v115
v_mfma_f32_32x32x16_bf16 v[48:63], v[156:159], v[164:167], v[48:63]
v_add_f32 v5, v5, v114
v_exp_f32 v116, v116
v_add_f32 v5, v5, v115
v_cvt_pk_bf16_f32 v113, v114, v115
v_exp_f32 v117, v117
v_add_f32 v5, v5, v116
v_exp_f32 v118, v118
v_mfma_f32_32x32x16_bf16 v[64:79], v[132:135], v[164:167], v[64:79]
v_add_f32 v5, v5, v117
v_cvt_pk_bf16_f32 v114, v116, v117
v_exp_f32 v119, v119
v_add_f32 v5, v5, v118
v_cvt_pk_bf16_f32 v115, v118, v119
v_add_f32 v5, v5, v119
s_waitcnt lgkmcnt(3)
v_mfma_f32_32x32x16_bf16 v[32:47], v[140:143], v[112:115], v[32:47]
v_exp_f32 v120, v120
v_exp_f32 v121, v121
v_add_f32 v5, v5, v120
v_exp_f32 v122, v122
v_add_f32 v5, v5, v121
v_cvt_pk_bf16_f32 v164, v120, v121
v_exp_f32 v123, v123
v_mfma_f32_32x32x16_bf16 v[48:63], v[144:147], v[112:115], v[48:63]
v_add_f32 v5, v5, v122
v_exp_f32 v124, v124
v_add_f32 v5, v5, v123
v_cvt_pk_bf16_f32 v165, v122, v123
v_exp_f32 v125, v125
v_add_f32 v5, v5, v124
v_exp_f32 v126, v126
v_mfma_f32_32x32x16_bf16 v[64:79], v[152:155], v[112:115], v[64:79]
v_add_f32 v5, v5, v125
v_cvt_pk_bf16_f32 v166, v124, v125
v_exp_f32 v127, v127
v_add_f32 v5, v5, v126
v_cvt_pk_bf16_f32 v167, v126, v127
v_add_f32 v5, v5, v127
s_waitcnt lgkmcnt(0)
v_mfma_f32_32x32x16_bf16 v[32:47], v[128:131], v[164:167], v[32:47]
v_mfma_f32_32x32x16_bf16 v[48:63], v[136:139], v[164:167], v[48:63]
v_mfma_f32_32x32x16_bf16 v[64:79], v[148:151], v[164:167], v[64:79]
v_mov_b32 v7, v5
s_nop 1
v_permlane32_swap_b32 v5, v7
s_nop 1
v_add_f32 v7, v5, v7
v_cmp_ngt_f32 vcc, 0x5d800000, v7
s_nop 1
s_cbranch_vccnz L_slow
L_slow_ret:
s_mul_i32 s56, s63, 12288
s_mul_i32 s57, s44, 6144
s_xor_b32 s66, s44, 1
s_mul_i32 s66, s66, 6144
v_add_u32 v2, s57, v4
v_and_b32 v161, 31, v0
v_lshlrev_b32 v94, 3, v161
s_lshl_b32 s67, s44, 8
s_add_u32 s67, s67, 160256
s_xor_b32 s68, s67, 256
v_add_u32 v162, s67, v94
ds_write_b64 v162, v[6:7]
s_lshl_b32 s67, s44, 2
s_add_u32 s67, s67, 159744
v_mov_b32 v160, s67
v_mov_b32 v1, 1
s_cmp_eq_u32 s45, 1
s_cbranch_scc1 L_ep1
ds_write_b128 v2, v[56:59] offset:0
ds_write_b128 v2, v[60:63] offset:1024
ds_write_b128 v2, v[64:67] offset:2048
ds_write_b128 v2, v[68:71] offset:3072
ds_write_b128 v2, v[72:75] offset:4096
ds_write_b128 v2, v[76:79] offset:5120
s_branch L_ep2
L_ep1:
ds_write_b128 v2, v[32:35] offset:0
ds_write_b128 v2, v[36:39] offset:1024
ds_write_b128 v2, v[40:43] offset:2048
ds_write_b128 v2, v[44:47] offset:3072
ds_write_b128 v2, v[48:51] offset:4096
ds_write_b128 v2, v[52:55] offset:5120
L_ep2:
ds_write_b32 v160, v1
v_add_u32 v3, s66, v4
v_add_u32 v162, s68, v94
v_xor_b32 v164, 4, v160
v_mul_u32_u24 v94, 112, v161
v_lshrrev_b32 v95, 5, v0
v_lshl_add_u32 v94, v95, 3, v94
v_add_u32 v94, s66, v94
v_mul_u32_u24 v92, 43, v0
v_lshrrev_b32 v92, 9, v92
v_mul_u32_u24 v93, 12, v92
v_sub_u32 v93, v0, v93
v_mul_u32_u24 v88, 112, v92
v_lshl_add_u32 v88, v93, 4, v88
v_cmp_gt_u32 vcc, 6, v93
v_mov_b32 v92, -96
v_mov_b32 v93, 6144
v_cndmask_b32 v92, v92, v93, vcc
s_mul_i32 s57, s45, 1792
s_add_u32 s56, s56, s57
v_add3_u32 v88, v88, v92, s56
s_lshr_b32 s57, s46, 1
s_cmp_eq_u32 s57, 1
s_cselect_b32 s69, s49, s48
s_cmp_eq_u32 s57, 2
s_cselect_b32 s69, s50, s69
s_and_b32 s57, s46, 1
s_lshl_b32 s57, s57, 1
s_add_u32 s57, s57, s45
s_mul_i32 s57, s57, 86016
s_add_u32 s69, s69, s57
s_add_u32 s68, s69, 43008
s_mul_i32 s67, s45, 24
L_sp1:
ds_read_b32 v167, v164
s_waitcnt lgkmcnt(0)
v_readfirstlane_b32 s56, v167
s_nop 3
s_cmp_eq_u32 s56, 1
s_cbranch_scc1 L_sp1_done
s_sleep 1
s_branch L_sp1
L_sp1_done:
ds_read_b64 v[8:9], v162
ds_read_b128 v[96:99], v3 offset:0
ds_read_b128 v[100:103], v3 offset:1024
ds_read_b128 v[104:107], v3 offset:2048
ds_read_b128 v[108:111], v3 offset:3072
ds_read_b128 v[112:115], v3 offset:4096
ds_read_b128 v[116:119], v3 offset:5120
s_waitcnt lgkmcnt(6)
v_max_f32 v10, v6, v8
v_sub_f32 v6, v6, v10
v_sub_f32 v8, v8, v10
v_exp_f32 v6, v6
v_exp_f32 v8, v8
s_nop 0
v_mul_f32 v7, v7, v6
v_fmac_f32 v7, v9, v8
v_rcp_f32 v7, v7
s_nop 0
v_mul_f32 v6, v6, v7
v_mul_f32 v8, v8, v7
s_set_gpr_idx_on s67, 0x1
s_nop 0
v_mul_f32 v128, v32, v6
v_mul_f32 v129, v33, v6
v_mul_f32 v130, v34, v6
v_mul_f32 v131, v35, v6
v_mul_f32 v132, v36, v6
v_mul_f32 v133, v37, v6
v_mul_f32 v134, v38, v6
v_mul_f32 v135, v39, v6
v_mul_f32 v136, v40, v6
v_mul_f32 v137, v41, v6
v_mul_f32 v138, v42, v6
v_mul_f32 v139, v43, v6
v_mul_f32 v140, v44, v6
v_mul_f32 v141, v45, v6
v_mul_f32 v142, v46, v6
v_mul_f32 v143, v47, v6
v_mul_f32 v144, v48, v6
v_mul_f32 v145, v49, v6
v_mul_f32 v146, v50, v6
v_mul_f32 v147, v51, v6
v_mul_f32 v148, v52, v6
v_mul_f32 v149, v53, v6
v_mul_f32 v150, v54, v6
v_mul_f32 v151, v55, v6
s_set_gpr_idx_off
s_waitcnt lgkmcnt(5)
v_fmac_f32 v128, v96, v8
v_fmac_f32 v129, v97, v8
v_fmac_f32 v130, v98, v8
v_fmac_f32 v131, v99, v8
v_cvt_pk_bf16_f32 v12, v128, v129
v_cvt_pk_bf16_f32 v13, v130, v131
s_waitcnt lgkmcnt(4)
v_fmac_f32 v132, v100, v8
v_fmac_f32 v133, v101, v8
v_fmac_f32 v134, v102, v8
v_fmac_f32 v135, v103, v8
v_cvt_pk_bf16_f32 v14, v132, v133
v_cvt_pk_bf16_f32 v15, v134, v135
s_waitcnt lgkmcnt(3)
v_fmac_f32 v136, v104, v8
v_fmac_f32 v137, v105, v8
v_fmac_f32 v138, v106, v8
v_fmac_f32 v139, v107, v8
v_cvt_pk_bf16_f32 v16, v136, v137
v_cvt_pk_bf16_f32 v17, v138, v139
s_waitcnt lgkmcnt(2)
v_fmac_f32 v140, v108, v8
v_fmac_f32 v141, v109, v8
v_fmac_f32 v142, v110, v8
v_fmac_f32 v143, v111, v8
v_cvt_pk_bf16_f32 v18, v140, v141
v_cvt_pk_bf16_f32 v19, v142, v143
s_waitcnt lgkmcnt(1)
v_fmac_f32 v144, v112, v8
v_fmac_f32 v145, v113, v8
v_fmac_f32 v146, v114, v8
v_fmac_f32 v147, v115, v8
v_cvt_pk_bf16_f32 v20, v144, v145
v_cvt_pk_bf16_f32 v21, v146, v147
s_waitcnt lgkmcnt(0)
v_fmac_f32 v148, v116, v8
v_fmac_f32 v149, v117, v8
v_fmac_f32 v150, v118, v8
v_fmac_f32 v151, v119, v8
v_cvt_pk_bf16_f32 v22, v148, v149
v_cvt_pk_bf16_f32 v23, v150, v151
s_waitcnt lgkmcnt(0)
ds_write_b64 v94, v[12:13] offset:0
ds_write_b64 v94, v[14:15] offset:16
ds_write_b64 v94, v[16:17] offset:32
ds_write_b64 v94, v[18:19] offset:48
ds_write_b64 v94, v[20:21] offset:64
ds_write_b64 v94, v[22:23] offset:80
ds_write_b32 v160, v1 offset:64
v_add_u32 v164, 64, v164
L_sp2:
ds_read_b32 v167, v164
s_waitcnt lgkmcnt(0)
v_readfirstlane_b32 s56, v167
s_nop 3
s_cmp_eq_u32 s56, 1
s_cbranch_scc1 L_sp2_done
s_sleep 1
s_branch L_sp2
L_sp2_done:
s_mov_b32 exec_hi, 0xffff
ds_read_b128 v[96:99], v88 offset:0
ds_read_b128 v[100:103], v88 offset:448
ds_read_b128 v[104:107], v88 offset:896
ds_read_b128 v[108:111], v88 offset:1344
s_waitcnt lgkmcnt(3)
buffer_store_dwordx4 v[96:99], v4, s[40:43], s69 offen offset:0 sc1
s_waitcnt lgkmcnt(2)
buffer_store_dwordx4 v[100:103], v4, s[40:43], s69 offen offset:768 sc1
s_waitcnt lgkmcnt(1)
buffer_store_dwordx4 v[104:107], v4, s[40:43], s68 offen offset:0 sc1
s_waitcnt lgkmcnt(0)
buffer_store_dwordx4 v[108:111], v4, s[40:43], s68 offen offset:768 sc1
s_mov_b32 exec_hi, -1
s_cmp_ge_u32 s44, 2
s_cbranch_scc1 L_fin
s_lshl_b32 s56, s44, 6
v_add_u32 v8, s56, v0
v_cmp_gt_u32 vcc, 96, v8
s_and_saveexec_b64 s[66:67], vcc
v_lshlrev_b32 v9, 4, v8
v_add_u32 v9, 147456, v9
v_and_b32 v10, 3, v8
v_lshlrev_b32 v11, 3, v10
v_add_u32 v11, 160000, v11
ds_read_b64 v[16:17], v11 offset:0
ds_read_b64 v[18:19], v11 offset:32
ds_read_b64 v[20:21], v11 offset:64
ds_read_b64 v[22:23], v11 offset:96
ds_read_b64 v[24:25], v11 offset:128
ds_read_b64 v[26:27], v11 offset:160
ds_read_b64 v[28:29], v11 offset:192
ds_read_b64 v[30:31], v11 offset:224
ds_read_b128 v[32:35], v9 offset:0
ds_read_b128 v[36:39], v9 offset:1536
ds_read_b128 v[40:43], v9 offset:3072
ds_read_b128 v[44:47], v9 offset:4608
ds_read_b128 v[48:51], v9 offset:6144
ds_read_b128 v[52:55], v9 offset:7680
ds_read_b128 v[56:59], v9 offset:9216
ds_read_b128 v[60:63], v9 offset:10752
s_waitcnt lgkmcnt(8)
v_max3_f32 v12, v16, v18, v20
v_max3_f32 v12, v12, v22, v24
v_max3_f32 v12, v12, v26, v28
v_max_f32 v12, v12, v30
v_sub_f32 v16, v16, v12
v_sub_f32 v18, v18, v12
v_sub_f32 v20, v20, v12
v_sub_f32 v22, v22, v12
v_sub_f32 v24, v24, v12
v_sub_f32 v26, v26, v12
v_sub_f32 v28, v28, v12
v_sub_f32 v30, v30, v12
v_exp_f32 v16, v16
v_exp_f32 v18, v18
v_exp_f32 v20, v20
v_exp_f32 v22, v22
v_exp_f32 v24, v24
v_exp_f32 v26, v26
v_exp_f32 v28, v28
v_exp_f32 v30, v30
s_nop 0
v_mul_f32 v13, v16, v17
v_fmac_f32 v13, v18, v19
v_fmac_f32 v13, v20, v21
v_fmac_f32 v13, v22, v23
v_fmac_f32 v13, v24, v25
v_fmac_f32 v13, v26, v27
v_fmac_f32 v13, v28, v29
v_fmac_f32 v13, v30, v31
v_rcp_f32 v13, v13
s_waitcnt lgkmcnt(0)
v_mul_f32 v64, v32, v16
v_mul_f32 v65, v33, v16
v_mul_f32 v66, v34, v16
v_mul_f32 v67, v35, v16
v_fmac_f32 v64, v36, v18
v_fmac_f32 v65, v37, v18
v_fmac_f32 v66, v38, v18
v_fmac_f32 v67, v39, v18
v_fmac_f32 v64, v40, v20
v_fmac_f32 v65, v41, v20
v_fmac_f32 v66, v42, v20
v_fmac_f32 v67, v43, v20
v_fmac_f32 v64, v44, v22
v_fmac_f32 v65, v45, v22
v_fmac_f32 v66, v46, v22
v_fmac_f32 v67, v47, v22
v_fmac_f32 v64, v48, v24
v_fmac_f32 v65, v49, v24
v_fmac_f32 v66, v50, v24
v_fmac_f32 v67, v51, v24
v_fmac_f32 v64, v52, v26
v_fmac_f32 v65, v53, v26
v_fmac_f32 v66, v54, v26
v_fmac_f32 v67, v55, v26
v_fmac_f32 v64, v56, v28
v_fmac_f32 v65, v57, v28
v_fmac_f32 v66, v58, v28
v_fmac_f32 v67, v59, v28
v_fmac_f32 v64, v60, v30
v_fmac_f32 v65, v61, v30
v_fmac_f32 v66, v62, v30
v_fmac_f32 v67, v63, v30
v_mul_f32 v64, v64, v13
v_mul_f32 v65, v65, v13
v_mul_f32 v66, v66, v13
v_mul_f32 v67, v67, v13
v_cvt_pk_bf16_f32 v64, v64, v65
v_cvt_pk_bf16_f32 v65, v66, v67
v_mul_u32_u24 v10, 192, v10
v_lshrrev_b32 v11, 2, v8
v_lshl_add_u32 v10, v11, 3, v10
s_bfe_u32 s56, s1, 0x10003
s_lshl_b32 s56, s56, 2
s_lshr_b32 s57, s58, 1
s_add_u32 s56, s56, s57
s_mul_i32 s56, s56, 43008
s_and_b32 s57, s58, 1
s_mul_i32 s57, s57, 768
s_add_u32 s56, s56, s57
s_add_u32 s56, s56, s51
buffer_store_dwordx2 v[64:65], v10, s[40:43], s56 offen sc1
s_mov_b64 exec, -1
L_fin:
L_end:
s_endpgm
L_slow:
s_lshr_b32 s67, 0xa5a, s44
s_and_b32 s67, s67, 1
s_add_u32 s66, s58, s45
s_and_b32 s66, s66, 1
v_mov_b32 v6, 0xff800000
s_mov_b32 s68, 0
L_sl_pass:
s_mov_b32 s69, s66
L_sl_tile:
s_mul_i32 s56, s69, 12288
s_add_u32 s57, s56, 4096
buffer_load_dwordx4 v[128:131], v4, s[36:39], s56 offen offset:0 sc1
buffer_load_dwordx4 v[132:135], v4, s[36:39], s56 offen offset:1024 sc1
buffer_load_dwordx4 v[136:139], v4, s[36:39], s56 offen offset:2048 sc1
buffer_load_dwordx4 v[140:143], v4, s[36:39], s56 offen offset:3072 sc1
buffer_load_dwordx4 v[144:147], v4, s[36:39], s57 offen offset:0 sc1
buffer_load_dwordx4 v[148:151], v4, s[36:39], s57 offen offset:1024 sc1
s_waitcnt vmcnt(0)
s_cmp_eq_u32 s68, 1
s_cbranch_scc1 L_sl_p2
v_mfma_f32_32x32x16_bf16 v[96:111], v[128:131], v[8:11], 0
v_mfma_f32_32x32x16_bf16 v[96:111], v[132:135], v[12:15], v[96:111]
v_mfma_f32_32x32x16_bf16 v[96:111], v[136:139], v[16:19], v[96:111]
v_mfma_f32_32x32x16_bf16 v[96:111], v[140:143], v[20:23], v[96:111]
v_mfma_f32_32x32x16_bf16 v[96:111], v[144:147], v[24:27], v[96:111]
v_mfma_f32_32x32x16_bf16 v[96:111], v[148:151], v[28:31], v[96:111]
s_nop 15
v_max3_f32 v6, v6, v96, v97
v_max3_f32 v6, v6, v98, v99
v_max3_f32 v6, v6, v100, v101
v_max3_f32 v6, v6, v102, v103
s_cmp_eq_u32 s69, 24
s_cbranch_scc1 L_sl_next
v_max3_f32 v6, v6, v104, v105
v_max3_f32 v6, v6, v106, v107
v_max3_f32 v6, v6, v108, v109
v_max3_f32 v6, v6, v110, v111
s_branch L_sl_next
L_sl_p2:
v_mfma_f32_32x32x16_bf16 v[96:111], v[128:131], v[8:11], v[80:95]
v_mfma_f32_32x32x16_bf16 v[96:111], v[132:135], v[12:15], v[96:111]
v_mfma_f32_32x32x16_bf16 v[96:111], v[136:139], v[16:19], v[96:111]
v_mfma_f32_32x32x16_bf16 v[96:111], v[140:143], v[20:23], v[96:111]
v_mfma_f32_32x32x16_bf16 v[96:111], v[144:147], v[24:27], v[96:111]
v_mfma_f32_32x32x16_bf16 v[96:111], v[148:151], v[28:31], v[96:111]
s_add_u32 s56, s56, 6144
s_add_u32 s57, s56, 4096
s_nop 7
buffer_load_dwordx4 v[128:131], v4, s[36:39], s56 offen offset:0 sc1
buffer_load_dwordx4 v[132:135], v4, s[36:39], s56 offen offset:1024 sc1
buffer_load_dwordx4 v[136:139], v4, s[36:39], s56 offen offset:2048 sc1
buffer_load_dwordx4 v[140:143], v4, s[36:39], s56 offen offset:3072 sc1
buffer_load_dwordx4 v[144:147], v4, s[36:39], s57 offen offset:0 sc1
buffer_load_dwordx4 v[148:151], v4, s[36:39], s57 offen offset:1024 sc1
s_nop 7
v_exp_f32 v96, v96
v_exp_f32 v97, v97
v_add_f32 v5, v5, v96
v_exp_f32 v98, v98
v_add_f32 v5, v5, v97
v_cvt_pk_bf16_f32 v96, v96, v97
v_exp_f32 v99, v99
v_add_f32 v5, v5, v98
v_exp_f32 v100, v100
v_add_f32 v5, v5, v99
v_cvt_pk_bf16_f32 v97, v98, v99
v_exp_f32 v101, v101
v_add_f32 v5, v5, v100
v_exp_f32 v102, v102
v_add_f32 v5, v5, v101
v_cvt_pk_bf16_f32 v98, v100, v101
v_exp_f32 v103, v103
v_add_f32 v5, v5, v102
v_cvt_pk_bf16_f32 v99, v102, v103
v_add_f32 v5, v5, v103
s_waitcnt vmcnt(0)
v_mfma_f32_32x32x16_bf16 v[32:47], v[128:131], v[96:99], v[32:47]
v_mfma_f32_32x32x16_bf16 v[48:63], v[132:135], v[96:99], v[48:63]
v_mfma_f32_32x32x16_bf16 v[64:79], v[136:139], v[96:99], v[64:79]
s_cmp_eq_u32 s69, 24
s_cbranch_scc1 L_sl_next
v_exp_f32 v104, v104
v_exp_f32 v105, v105
v_add_f32 v5, v5, v104
v_exp_f32 v106, v106
v_add_f32 v5, v5, v105
v_cvt_pk_bf16_f32 v164, v104, v105
v_exp_f32 v107, v107
v_add_f32 v5, v5, v106
v_exp_f32 v108, v108
v_add_f32 v5, v5, v107
v_cvt_pk_bf16_f32 v165, v106, v107
v_exp_f32 v109, v109
v_add_f32 v5, v5, v108
v_exp_f32 v110, v110
v_add_f32 v5, v5, v109
v_cvt_pk_bf16_f32 v166, v108, v109
v_exp_f32 v111, v111
v_add_f32 v5, v5, v110
v_cvt_pk_bf16_f32 v167, v110, v111
v_add_f32 v5, v5, v111
s_nop 1
v_mfma_f32_32x32x16_bf16 v[32:47], v[140:143], v[164:167], v[32:47]
v_mfma_f32_32x32x16_bf16 v[48:63], v[144:147], v[164:167], v[48:63]
v_mfma_f32_32x32x16_bf16 v[64:79], v[148:151], v[164:167], v[64:79]
L_sl_next:
s_nop 7
s_cmp_eq_u32 s69, 24
s_cbranch_scc1 L_sl_endpass
s_add_u32 s69, s69, 2
s_cmp_lt_u32 s69, 24
s_cbranch_scc1 L_sl_tile
s_mov_b32 s69, 24
s_cmp_eq_u32 s67, 1
s_cbranch_scc1 L_sl_tile
L_sl_endpass:
s_cmp_eq_u32 s68, 1
s_cbranch_scc1 L_sl_done
v_mov_b32 v7, v6
s_nop 1
v_permlane32_swap_b32 v6, v7
s_nop 1
v_max_f32 v6, v6, v7
v_sub_f32 v80, 0, v6
v_sub_f32 v81, 0, v6
v_sub_f32 v82, 0, v6
v_sub_f32 v83, 0, v6
v_sub_f32 v84, 0, v6
v_sub_f32 v85, 0, v6
v_sub_f32 v86, 0, v6
v_sub_f32 v87, 0, v6
v_sub_f32 v88, 0, v6
v_sub_f32 v89, 0, v6
v_sub_f32 v90, 0, v6
v_sub_f32 v91, 0, v6
v_sub_f32 v92, 0, v6
v_sub_f32 v93, 0, v6
v_sub_f32 v94, 0, v6
v_sub_f32 v95, 0, v6
v_mov_b32 v32, 0
v_mov_b32 v33, 0
v_mov_b32 v34, 0
v_mov_b32 v35, 0
v_mov_b32 v36, 0
v_mov_b32 v37, 0
v_mov_b32 v38, 0
v_mov_b32 v39, 0
v_mov_b32 v40, 0
v_mov_b32 v41, 0
v_mov_b32 v42, 0
v_mov_b32 v43, 0
v_mov_b32 v44, 0
v_mov_b32 v45, 0
v_mov_b32 v46, 0
v_mov_b32 v47, 0
v_mov_b32 v48, 0
v_mov_b32 v49, 0
v_mov_b32 v50, 0
v_mov_b32 v51, 0
v_mov_b32 v52, 0
v_mov_b32 v53, 0
v_mov_b32 v54, 0
v_mov_b32 v55, 0
v_mov_b32 v56, 0
v_mov_b32 v57, 0
v_mov_b32 v58, 0
v_mov_b32 v59, 0
v_mov_b32 v60, 0
v_mov_b32 v61, 0
v_mov_b32 v62, 0
v_mov_b32 v63, 0
v_mov_b32 v64, 0
v_mov_b32 v65, 0
v_mov_b32 v66, 0
v_mov_b32 v67, 0
v_mov_b32 v68, 0
v_mov_b32 v69, 0
v_mov_b32 v70, 0
v_mov_b32 v71, 0
v_mov_b32 v72, 0
v_mov_b32 v73, 0
v_mov_b32 v74, 0
v_mov_b32 v75, 0
v_mov_b32 v76, 0
v_mov_b32 v77, 0
v_mov_b32 v78, 0
v_mov_b32 v79, 0
v_mov_b32 v5, 0
s_mov_b32 s68, 1
s_branch L_sl_pass
L_sl_done:
s_nop 7
v_mov_b32 v7, v5
s_nop 1
v_permlane32_swap_b32 v5, v7
s_nop 1
v_add_f32 v7, v5, v7
s_branch L_slow_ret
L_walk2:
s_branch L_polled
.section .rodata,"a"
.p2align 6
.amdhsa_kernel standalone__window_attn_twins__vision_kernel
  .amdhsa_next_free_vgpr 168
  .amdhsa_next_free_sgpr 102
  .amdhsa_accum_offset 168
  .amdhsa_group_segment_fixed_size 0
  .amdhsa_kernarg_size 56
  .amdhsa_user_sgpr_count 2
  .amdhsa_user_sgpr_kernarg_segment_ptr 1
  .amdhsa_system_sgpr_workgroup_id_x 1
.end_amdhsa_kernel
```
